```python
import torch

def _softmax(x, axis=-1):
    return torch.softmax(x, dim=axis)
def _gelu(x):
    return torch.nn.functional.gelu(x, approximate="tanh")
def _silu(x):
    return torch.nn.functional.silu(x)
def _sigmoid(x):
    return torch.sigmoid(x)
def _layernorm(x, axis=-1, eps=1e-5):
    m = x.mean(dim=axis, keepdim=True)
    v = x.var(dim=axis, keepdim=True, unbiased=False)
    return (x - m) / torch.sqrt(v + eps)
def _scatter_add(tgt, idx, src, axis=0):
    return tgt.clone().index_add_(axis, idx, src)
def _segment_sum(src, seg, n):
    out = torch.zeros((n,) + src.shape[1:], dtype=src.dtype)
    return out.index_add_(0, seg, src)
def _pad(x, pw):
    flat = tuple(v for pair in reversed(pw) for v in pair)
    return torch.nn.functional.pad(x, flat)

kernel_name = 'standalone__channel_attn_se__vision'

def setup_inputs():

    _w = (lambda a: (lambda t: t.to(torch.bfloat16) if t.is_floating_point() else t)(torch.as_tensor(a)))
    H = W = 512
    C = 96
    r = max(C // 16, 4)
    return {
        "x": _w((lambda *s: torch.randn(*s, dtype=torch.bfloat16) * 3.2)(1, H, W, C)),
        "w_down": _w((lambda *s: torch.randn(*s, dtype=torch.bfloat16) * 12.8)(C, r)),
        "w_up": _w((lambda *s: torch.randn(*s, dtype=torch.bfloat16) * 3.2)(r, C)),
    }

def reference(x, w_down, w_up):
    s = x.mean(axis=(1, 2))
    h = _silu(torch.einsum('bc,cr->br', s, w_down))
    g = _sigmoid(torch.einsum('br,rc->bc', h, w_up))
    return x * g[:, None, None, :]
```

```asm
; @launch grid=(256,1,1) block=(1024,1,1) lds=1024
.amdgcn_target "amdgcn-amd-amdhsa--gfx950"
.text
.globl standalone__channel_attn_se__vision_kernel
.p2align 8
.type standalone__channel_attn_se__vision_kernel,@function
standalone__channel_attn_se__vision_kernel:
    s_cmp_ge_u32 s2, 256
    s_cbranch_scc1 L_end
    s_load_dwordx4 s[4:7], s[0:1], 0
    s_load_dwordx4 s[8:11], s[0:1], 16
    s_load_dwordx4 s[12:15], s[0:1], 32
    v_lshrrev_b32 v1, 6, v0
    v_and_b32 v2, 63, v0
    v_mul_u32_u24 v3, 12, v2
    v_readfirstlane_b32 s26, v1
    v_and_b32 v14, 15, v2
    v_mov_b32 v15, 0x3f80
    v_mov_b32 v13, 0x3f800000
    v_mov_b32 v4, 0
    v_mov_b32 v5, 0
    v_mov_b32 v6, 0
    v_mov_b32 v7, 0
    v_cmp_eq_u32 vcc, 0, v14
    s_nop 1
    v_cndmask_b32 v4, v4, v15, vcc
    v_cmp_eq_u32 vcc, 1, v14
    s_nop 1
    v_cndmask_b32 v4, v4, v13, vcc
    v_cmp_eq_u32 vcc, 2, v14
    s_nop 1
    v_cndmask_b32 v5, v5, v15, vcc
    v_cmp_eq_u32 vcc, 3, v14
    s_nop 1
    v_cndmask_b32 v5, v5, v13, vcc
    v_cmp_eq_u32 vcc, 4, v14
    s_nop 1
    v_cndmask_b32 v6, v6, v15, vcc
    v_cmp_eq_u32 vcc, 5, v14
    s_nop 1
    v_cndmask_b32 v6, v6, v13, vcc
    v_cmp_eq_u32 vcc, 6, v14
    s_nop 1
    v_cndmask_b32 v7, v7, v15, vcc
    v_cmp_eq_u32 vcc, 7, v14
    s_nop 1
    v_cndmask_b32 v7, v7, v13, vcc
    v_mov_b32 v8, 0
    v_mov_b32 v9, 0
    v_mov_b32 v10, 0
    v_mov_b32 v11, 0
    v_mov_b32 v19, 0
    v_mov_b32 v23, 0
    v_mov_b32 v27, 0
    v_mov_b32 v31, 0
    v_mov_b32 v35, 0
    v_mov_b32 v39, 0
    v_mov_b32 v43, 0
    v_mov_b32 v47, 0
    v_mov_b32 v51, 0
    v_mov_b32 v55, 0
    v_mov_b32 v59, 0
    v_mov_b32 v63, 0
    v_mov_b32 v67, 0
    v_mov_b32 v71, 0
    v_mov_b32 v75, 0
    v_mov_b32 v79, 0
    s_mul_i32 s27, s26, 768
    v_add_u32 v3, s27, v3
    s_mul_i32 s28, s2, 12288
    s_waitcnt lgkmcnt(0)
    s_add_u32 s16, s4, s28
    s_addc_u32 s17, s5, 0
    s_sub_u32 s18, 50331648, s28
    s_mov_b32 s19, 0x00020000
    s_add_u32 s20, s10, s28
    s_addc_u32 s21, s11, 0
    s_mov_b32 s22, s18
    s_mov_b32 s23, 0x00020000
    s_cmp_lg_u32 s2, 0
    s_cbranch_scc1 L_nozero
    v_lshlrev_b32 v14, 4, v0
    v_mov_b32 v96, 0
    v_mov_b32 v97, 0
    v_mov_b32 v98, 0
    v_mov_b32 v99, 0
    global_store_dwordx4 v14, v[96:99], s[14:15] sc1
L_nozero:
    s_cmp_lg_u32 s26, 0
    s_cbranch_scc1 L_noweights
    s_mov_b32 s32, s6
    s_mov_b32 s33, s7
    s_mov_b32 s34, 1152
    s_mov_b32 s35, 0x00020000
    s_mov_b32 s36, s8
    s_mov_b32 s37, s9
    s_mov_b32 s38, 1152
    s_mov_b32 s39, 0x00020000
    v_mul_u32_u24 v14, 24, v2
    v_lshlrev_b32 v15, 2, v2
    buffer_load_dwordx3 v[80:82], v14, s[32:35], 0 offen
    buffer_load_dwordx3 v[84:86], v14, s[32:35], 0 offen offset:12
    buffer_load_dword v88, v15, s[36:39], 0 offen offset:0
    buffer_load_dword v89, v15, s[36:39], 0 offen offset:192
    buffer_load_dword v90, v15, s[36:39], 0 offen offset:384
    buffer_load_dword v91, v15, s[36:39], 0 offen offset:576
    buffer_load_dword v92, v15, s[36:39], 0 offen offset:768
    buffer_load_dword v93, v15, s[36:39], 0 offen offset:960
L_noweights:
    s_mov_b32 s24, 0
    buffer_load_dwordx3 v[16:18], v3, s[16:19], s24 offen nt
    s_add_u32 s24, s24, 3145728
    buffer_load_dwordx3 v[20:22], v3, s[16:19], s24 offen nt
    s_add_u32 s24, s24, 3145728
    buffer_load_dwordx3 v[24:26], v3, s[16:19], s24 offen nt
    s_add_u32 s24, s24, 3145728
    buffer_load_dwordx3 v[28:30], v3, s[16:19], s24 offen nt
    s_add_u32 s24, s24, 3145728
    buffer_load_dwordx3 v[32:34], v3, s[16:19], s24 offen nt
    s_add_u32 s24, s24, 3145728
    buffer_load_dwordx3 v[36:38], v3, s[16:19], s24 offen nt
    s_add_u32 s24, s24, 3145728
    buffer_load_dwordx3 v[40:42], v3, s[16:19], s24 offen nt
    s_add_u32 s24, s24, 3145728
    buffer_load_dwordx3 v[44:46], v3, s[16:19], s24 offen nt
    s_add_u32 s24, s24, 3145728
    buffer_load_dwordx3 v[48:50], v3, s[16:19], s24 offen nt
    s_add_u32 s24, s24, 3145728
    buffer_load_dwordx3 v[52:54], v3, s[16:19], s24 offen nt
    s_add_u32 s24, s24, 3145728
    buffer_load_dwordx3 v[56:58], v3, s[16:19], s24 offen nt
    s_add_u32 s24, s24, 3145728
    buffer_load_dwordx3 v[60:62], v3, s[16:19], s24 offen nt
    s_add_u32 s24, s24, 3145728
    buffer_load_dwordx3 v[64:66], v3, s[16:19], s24 offen nt
    s_add_u32 s24, s24, 3145728
    buffer_load_dwordx3 v[68:70], v3, s[16:19], s24 offen nt
    s_add_u32 s24, s24, 3145728
    buffer_load_dwordx3 v[72:74], v3, s[16:19], s24 offen nt
    s_add_u32 s24, s24, 3145728
    buffer_load_dwordx3 v[76:78], v3, s[16:19], s24 offen nt
    s_add_u32 s24, s24, 3145728
    v_lshlrev_b32 v12, 2, v0
    v_mov_b32 v14, 0
    v_cmp_gt_u32 vcc, 128, v0
    s_and_saveexec_b64 s[30:31], vcc
    ds_write_b32 v12, v14
    s_mov_b64 exec, s[30:31]
    s_cmp_lg_u32 s2, 0
    s_cbranch_scc1 L_nozwait
    s_waitcnt vmcnt(16)
L_nozwait:
    s_waitcnt lgkmcnt(0)
    s_barrier
    s_or_b32 s29, s2, s26
    s_cmp_lg_u32 s29, 0
    s_cbranch_scc1 L_noflag
    v_mov_b32 v14, 0
    v_mov_b32 v15, 1
    s_mov_b64 s[30:31], exec
    s_mov_b64 exec, 1
    global_atomic_add v14, v15, s[12:13] sc1
    s_mov_b64 exec, s[30:31]
L_noflag:
    v_and_b32 v14, 15, v2
    v_mul_u32_u24 v12, 24, v14
    v_lshrrev_b32 v14, 4, v2
    v_lshl_add_u32 v12, v14, 4, v12
    v_mov_b32 v14, 0
    s_waitcnt vmcnt(15)
    v_mfma_f32_16x16x32_bf16 v[8:11], v[4:7], v[16:19], v[8:11]
    s_waitcnt vmcnt(14)
    v_mfma_f32_16x16x32_bf16 v[8:11], v[4:7], v[20:23], v[8:11]
    s_waitcnt vmcnt(13)
    v_mfma_f32_16x16x32_bf16 v[8:11], v[4:7], v[24:27], v[8:11]
    s_waitcnt vmcnt(12)
    v_mfma_f32_16x16x32_bf16 v[8:11], v[4:7], v[28:31], v[8:11]
    s_waitcnt vmcnt(11)
    v_mfma_f32_16x16x32_bf16 v[8:11], v[4:7], v[32:35], v[8:11]
    s_waitcnt vmcnt(10)
    v_mfma_f32_16x16x32_bf16 v[8:11], v[4:7], v[36:39], v[8:11]
    s_waitcnt vmcnt(9)
    v_mfma_f32_16x16x32_bf16 v[8:11], v[4:7], v[40:43], v[8:11]
    s_waitcnt vmcnt(8)
    v_mfma_f32_16x16x32_bf16 v[8:11], v[4:7], v[44:47], v[8:11]
    s_waitcnt vmcnt(7)
    v_mfma_f32_16x16x32_bf16 v[8:11], v[4:7], v[48:51], v[8:11]
    s_waitcnt vmcnt(6)
    v_mfma_f32_16x16x32_bf16 v[8:11], v[4:7], v[52:55], v[8:11]
    s_waitcnt vmcnt(5)
    v_mfma_f32_16x16x32_bf16 v[8:11], v[4:7], v[56:59], v[8:11]
    s_waitcnt vmcnt(4)
    v_mfma_f32_16x16x32_bf16 v[8:11], v[4:7], v[60:63], v[8:11]
    global_load_dword v13, v14, s[12:13] sc1
    s_waitcnt vmcnt(4)
    v_mfma_f32_16x16x32_bf16 v[8:11], v[4:7], v[64:67], v[8:11]
    s_waitcnt vmcnt(3)
    v_mfma_f32_16x16x32_bf16 v[8:11], v[4:7], v[68:71], v[8:11]
    s_waitcnt vmcnt(2)
    v_mfma_f32_16x16x32_bf16 v[8:11], v[4:7], v[72:75], v[8:11]
    s_waitcnt vmcnt(1)
    v_mfma_f32_16x16x32_bf16 v[8:11], v[4:7], v[76:79], v[8:11]
    s_nop 7
    s_mov_b32 exec_hi, 0
    ds_add_f32 v12, v8
    ds_add_f32 v12, v9 offset:4
    s_mov_b32 exec_lo, 0xffff
    ds_add_f32 v12, v10 offset:8
    ds_add_f32 v12, v11 offset:12
    s_mov_b64 exec, -1
    s_waitcnt lgkmcnt(0)
    s_barrier
    s_cmp_lg_u32 s26, 0
    s_cbranch_scc1 L_waitg
    s_waitcnt vmcnt(0)
    v_lshlrev_b32 v12, 2, v2
    ds_read_b32 v94, v12
    ds_read_b32 v95, v12 offset:256
    s_mov_b32 s31, 0
L_flagspin:
    v_readfirstlane_b32 s30, v13
    s_cmp_lg_u32 s30, 0
    s_cbranch_scc1 L_flagok
    s_add_u32 s31, s31, 1
    s_cmp_gt_u32 s31, 0x40000
    s_cbranch_scc1 L_flagok
    s_sleep 1
    global_load_dword v13, v14, s[12:13] sc1
    s_waitcnt vmcnt(0)
    s_branch L_flagspin
L_flagok:
    s_and_b32 s29, s2, 15
    s_mul_i32 s30, s29, 512
    v_add_u32 v15, s30, v12
    s_waitcnt lgkmcnt(0)
    global_atomic_add_f32 v15, v94, s[14:15] sc1
    s_mov_b32 exec_hi, 0
    global_atomic_add_f32 v15, v95, s[14:15] offset:256 sc1
    s_mov_b64 exec, -1
    s_mul_i32 s30, s29, 128
    s_add_u32 s30, s30, 8192
    v_mov_b32 v14, s30
    v_mov_b32 v15, 1
    v_lshlrev_b32 v12, 7, v2
    v_add_u32 v12, 8192, v12
    s_waitcnt vmcnt(0)
    s_mov_b64 exec, 1
    global_atomic_add v13, v14, v15, s[14:15] sc0 sc1
    s_waitcnt vmcnt(0)
    v_readfirstlane_b32 s30, v13
    s_cmp_lg_u32 s30, 15
    s_cbranch_scc1 L_gowait
    v_mov_b32 v14, 10240
    global_atomic_add v13, v14, v15, s[14:15] sc0 sc1
    s_waitcnt vmcnt(0)
    v_readfirstlane_b32 s30, v13
    s_cmp_lg_u32 s30, 15
    s_cbranch_scc1 L_gowait
    s_mov_b32 exec_lo, 0xffff
    v_add_u32 v12, 4096, v12
    v_mov_b32 v15, 1
    global_atomic_add v12, v15, s[14:15] sc1
    s_mov_b64 exec, 1
L_gowait:
    s_lshl_b32 s30, s29, 7
    s_add_u32 s30, s30, 12288
    v_mov_b32 v12, s30
    s_mov_b32 s31, 0
L_poll:
    global_load_dword v13, v12, s[14:15] sc1
    s_waitcnt vmcnt(0)
    v_cmp_ne_u32 vcc, 1, v13
    s_cbranch_vccz L_polldone
    s_add_u32 s31, s31, 1
    s_cmp_gt_u32 s31, 0x40000
    s_cbranch_scc1 L_polldone
    s_sleep 1
    s_branch L_poll
L_polldone:
    s_mov_b64 exec, -1
    v_lshlrev_b32 v12, 3, v2
    v_add_u32 v14, 4096, v12
    global_load_dwordx2 v[96:97], v12, s[14:15] offset:0 sc1
    global_load_dwordx2 v[98:99], v12, s[14:15] offset:512 sc1
    global_load_dwordx2 v[100:101], v12, s[14:15] offset:1024 sc1
    global_load_dwordx2 v[102:103], v12, s[14:15] offset:1536 sc1
    global_load_dwordx2 v[104:105], v12, s[14:15] offset:2048 sc1
    global_load_dwordx2 v[106:107], v12, s[14:15] offset:2560 sc1
    global_load_dwordx2 v[108:109], v12, s[14:15] offset:3072 sc1
    global_load_dwordx2 v[110:111], v12, s[14:15] offset:3584 sc1
    global_load_dwordx2 v[112:113], v14, s[14:15] offset:0 sc1
    global_load_dwordx2 v[114:115], v14, s[14:15] offset:512 sc1
    global_load_dwordx2 v[116:117], v14, s[14:15] offset:1024 sc1
    global_load_dwordx2 v[118:119], v14, s[14:15] offset:1536 sc1
    global_load_dwordx2 v[120:121], v14, s[14:15] offset:2048 sc1
    global_load_dwordx2 v[122:123], v14, s[14:15] offset:2560 sc1
    global_load_dwordx2 v[124:125], v14, s[14:15] offset:3072 sc1
    global_load_dwordx2 v[126:127], v14, s[14:15] offset:3584 sc1
    s_waitcnt vmcnt(0)
    v_add_f32 v96, v96, v98
    v_add_f32 v97, v97, v99
    v_add_f32 v100, v100, v102
    v_add_f32 v101, v101, v103
    v_add_f32 v104, v104, v106
    v_add_f32 v105, v105, v107
    v_add_f32 v108, v108, v110
    v_add_f32 v109, v109, v111
    v_add_f32 v112, v112, v114
    v_add_f32 v113, v113, v115
    v_add_f32 v116, v116, v118
    v_add_f32 v117, v117, v119
    v_add_f32 v120, v120, v122
    v_add_f32 v121, v121, v123
    v_add_f32 v124, v124, v126
    v_add_f32 v125, v125, v127
    v_add_f32 v96, v96, v100
    v_add_f32 v97, v97, v101
    v_add_f32 v104, v104, v108
    v_add_f32 v105, v105, v109
    v_add_f32 v112, v112, v116
    v_add_f32 v113, v113, v117
    v_add_f32 v120, v120, v124
    v_add_f32 v121, v121, v125
    v_add_f32 v96, v96, v104
    v_add_f32 v97, v97, v105
    v_add_f32 v112, v112, v120
    v_add_f32 v113, v113, v121
    v_add_f32 v96, v96, v112
    v_add_f32 v97, v97, v113
    v_mul_f32 v96, 0x36800000, v96
    v_mul_f32 v97, 0x36800000, v97
    v_cvt_pk_bf16_f32 v98, v96, v97
    v_lshlrev_b32 v96, 16, v98
    v_and_b32 v97, 0xffff0000, v98
    v_lshlrev_b32 v106, 16, v80
    v_lshlrev_b32 v107, 16, v84
    v_mul_f32 v100, v96, v106
    v_fmac_f32 v100, v97, v107
    v_and_b32 v106, 0xffff0000, v80
    v_and_b32 v107, 0xffff0000, v84
    v_mul_f32 v101, v96, v106
    v_fmac_f32 v101, v97, v107
    v_lshlrev_b32 v106, 16, v81
    v_lshlrev_b32 v107, 16, v85
    v_mul_f32 v102, v96, v106
    v_fmac_f32 v102, v97, v107
    v_and_b32 v106, 0xffff0000, v81
    v_and_b32 v107, 0xffff0000, v85
    v_mul_f32 v103, v96, v106
    v_fmac_f32 v103, v97, v107
    v_lshlrev_b32 v106, 16, v82
    v_lshlrev_b32 v107, 16, v86
    v_mul_f32 v104, v96, v106
    v_fmac_f32 v104, v97, v107
    v_and_b32 v106, 0xffff0000, v82
    v_and_b32 v107, 0xffff0000, v86
    v_mul_f32 v105, v96, v106
    v_fmac_f32 v105, v97, v107
    v_add_f32_dpp v106, v100, v100 row_ror:1 row_mask:0xf bank_mask:0xf
    v_add_f32_dpp v107, v101, v101 row_ror:1 row_mask:0xf bank_mask:0xf
    v_add_f32_dpp v108, v102, v102 row_ror:1 row_mask:0xf bank_mask:0xf
    v_add_f32_dpp v109, v103, v103 row_ror:1 row_mask:0xf bank_mask:0xf
    v_add_f32_dpp v110, v104, v104 row_ror:1 row_mask:0xf bank_mask:0xf
    v_add_f32_dpp v111, v105, v105 row_ror:1 row_mask:0xf bank_mask:0xf
    s_nop 1
    v_mov_b32 v100, v106
    v_mov_b32 v101, v107
    v_mov_b32 v102, v108
    v_mov_b32 v103, v109
    v_mov_b32 v104, v110
    v_mov_b32 v105, v111
    s_nop 1
    v_add_f32_dpp v106, v100, v100 row_ror:2 row_mask:0xf bank_mask:0xf
    v_add_f32_dpp v107, v101, v101 row_ror:2 row_mask:0xf bank_mask:0xf
    v_add_f32_dpp v108, v102, v102 row_ror:2 row_mask:0xf bank_mask:0xf
    v_add_f32_dpp v109, v103, v103 row_ror:2 row_mask:0xf bank_mask:0xf
    v_add_f32_dpp v110, v104, v104 row_ror:2 row_mask:0xf bank_mask:0xf
    v_add_f32_dpp v111, v105, v105 row_ror:2 row_mask:0xf bank_mask:0xf
    s_nop 1
    v_mov_b32 v100, v106
    v_mov_b32 v101, v107
    v_mov_b32 v102, v108
    v_mov_b32 v103, v109
    v_mov_b32 v104, v110
    v_mov_b32 v105, v111
    s_nop 1
    v_add_f32_dpp v106, v100, v100 row_ror:4 row_mask:0xf bank_mask:0xf
    v_add_f32_dpp v107, v101, v101 row_ror:4 row_mask:0xf bank_mask:0xf
    v_add_f32_dpp v108, v102, v102 row_ror:4 row_mask:0xf bank_mask:0xf
    v_add_f32_dpp v109, v103, v103 row_ror:4 row_mask:0xf bank_mask:0xf
    v_add_f32_dpp v110, v104, v104 row_ror:4 row_mask:0xf bank_mask:0xf
    v_add_f32_dpp v111, v105, v105 row_ror:4 row_mask:0xf bank_mask:0xf
    s_nop 1
    v_mov_b32 v100, v106
    v_mov_b32 v101, v107
    v_mov_b32 v102, v108
    v_mov_b32 v103, v109
    v_mov_b32 v104, v110
    v_mov_b32 v105, v111
    s_nop 1
    v_add_f32_dpp v106, v100, v100 row_ror:8 row_mask:0xf bank_mask:0xf
    v_add_f32_dpp v107, v101, v101 row_ror:8 row_mask:0xf bank_mask:0xf
    v_add_f32_dpp v108, v102, v102 row_ror:8 row_mask:0xf bank_mask:0xf
    v_add_f32_dpp v109, v103, v103 row_ror:8 row_mask:0xf bank_mask:0xf
    v_add_f32_dpp v110, v104, v104 row_ror:8 row_mask:0xf bank_mask:0xf
    v_add_f32_dpp v111, v105, v105 row_ror:8 row_mask:0xf bank_mask:0xf
    s_nop 1
    v_mov_b32 v100, v106
    v_mov_b32 v101, v107
    v_mov_b32 v102, v108
    v_mov_b32 v103, v109
    v_mov_b32 v104, v110
    v_mov_b32 v105, v111
    s_nop 1
    v_mov_b32 v106, v100
    v_mov_b32 v107, v101
    v_mov_b32 v108, v102
    v_mov_b32 v109, v103
    v_mov_b32 v110, v104
    v_mov_b32 v111, v105
    s_nop 1
    v_permlane16_swap_b32 v100, v106
    v_permlane16_swap_b32 v101, v107
    v_permlane16_swap_b32 v102, v108
    v_permlane16_swap_b32 v103, v109
    v_permlane16_swap_b32 v104, v110
    v_permlane16_swap_b32 v105, v111
    s_nop 1
    v_add_f32 v100, v100, v106
    v_add_f32 v101, v101, v107
    v_add_f32 v102, v102, v108
    v_add_f32 v103, v103, v109
    v_add_f32 v104, v104, v110
    v_add_f32 v105, v105, v111
    v_mov_b32 v106, v100
    v_mov_b32 v107, v101
    v_mov_b32 v108, v102
    v_mov_b32 v109, v103
    v_mov_b32 v110, v104
    v_mov_b32 v111, v105
    s_nop 1
    v_permlane32_swap_b32 v100, v106
    v_permlane32_swap_b32 v101, v107
    v_permlane32_swap_b32 v102, v108
    v_permlane32_swap_b32 v103, v109
    v_permlane32_swap_b32 v104, v110
    v_permlane32_swap_b32 v105, v111
    s_nop 1
    v_add_f32 v100, v100, v106
    v_add_f32 v101, v101, v107
    v_add_f32 v102, v102, v108
    v_add_f32 v103, v103, v109
    v_add_f32 v104, v104, v110
    v_add_f32 v105, v105, v111
    s_mov_b32 s30, 0xbfb8aa3b
    v_cvt_pk_bf16_f32 v106, v100, v101
    v_lshlrev_b32 v100, 16, v106
    v_and_b32 v101, 0xffff0000, v106
    v_cvt_pk_bf16_f32 v106, v102, v103
    v_lshlrev_b32 v102, 16, v106
    v_and_b32 v103, 0xffff0000, v106
    v_cvt_pk_bf16_f32 v106, v104, v105
    v_lshlrev_b32 v104, 16, v106
    v_and_b32 v105, 0xffff0000, v106
    v_mul_f32 v106, s30, v100
    v_mul_f32 v107, s30, v101
    v_mul_f32 v108, s30, v102
    v_mul_f32 v109, s30, v103
    v_mul_f32 v110, s30, v104
    v_mul_f32 v111, s30, v105
    v_exp_f32 v106, v106
    v_exp_f32 v107, v107
    v_exp_f32 v108, v108
    v_exp_f32 v109, v109
    v_exp_f32 v110, v110
    v_exp_f32 v111, v111
    s_nop 0
    v_add_f32 v106, 1.0, v106
    v_add_f32 v107, 1.0, v107
    v_add_f32 v108, 1.0, v108
    v_add_f32 v109, 1.0, v109
    v_add_f32 v110, 1.0, v110
    v_add_f32 v111, 1.0, v111
    v_rcp_f32 v106, v106
    v_rcp_f32 v107, v107
    v_rcp_f32 v108, v108
    v_rcp_f32 v109, v109
    v_rcp_f32 v110, v110
    v_rcp_f32 v111, v111
    s_nop 0
    v_mul_f32 v100, v100, v106
    v_mul_f32 v101, v101, v107
    v_mul_f32 v102, v102, v108
    v_mul_f32 v103, v103, v109
    v_mul_f32 v104, v104, v110
    v_mul_f32 v105, v105, v111
    v_cvt_pk_bf16_f32 v106, v100, v101
    v_lshlrev_b32 v100, 16, v106
    v_and_b32 v101, 0xffff0000, v106
    v_cvt_pk_bf16_f32 v106, v102, v103
    v_lshlrev_b32 v102, 16, v106
    v_and_b32 v103, 0xffff0000, v106
    v_cvt_pk_bf16_f32 v106, v104, v105
    v_lshlrev_b32 v104, 16, v106
    v_and_b32 v105, 0xffff0000, v106
    v_mov_b32 v96, 0
    v_mov_b32 v97, 0
    v_lshlrev_b32 v106, 16, v88
    v_and_b32 v107, 0xffff0000, v88
    v_fmac_f32 v96, v100, v106
    v_fmac_f32 v97, v100, v107
    v_lshlrev_b32 v106, 16, v89
    v_and_b32 v107, 0xffff0000, v89
    v_fmac_f32 v96, v101, v106
    v_fmac_f32 v97, v101, v107
    v_lshlrev_b32 v106, 16, v90
    v_and_b32 v107, 0xffff0000, v90
    v_fmac_f32 v96, v102, v106
    v_fmac_f32 v97, v102, v107
    v_lshlrev_b32 v106, 16, v91
    v_and_b32 v107, 0xffff0000, v91
    v_fmac_f32 v96, v103, v106
    v_fmac_f32 v97, v103, v107
    v_lshlrev_b32 v106, 16, v92
    v_and_b32 v107, 0xffff0000, v92
    v_fmac_f32 v96, v104, v106
    v_fmac_f32 v97, v104, v107
    v_lshlrev_b32 v106, 16, v93
    v_and_b32 v107, 0xffff0000, v93
    v_fmac_f32 v96, v105, v106
    v_fmac_f32 v97, v105, v107
    v_cvt_pk_bf16_f32 v98, v96, v97
    v_lshlrev_b32 v96, 16, v98
    v_and_b32 v97, 0xffff0000, v98
    v_mul_f32 v96, s30, v96
    v_mul_f32 v97, s30, v97
    v_exp_f32 v96, v96
    v_exp_f32 v97, v97
    s_nop 0
    v_add_f32 v96, 1.0, v96
    v_add_f32 v97, 1.0, v97
    v_rcp_f32 v96, v96
    v_rcp_f32 v97, v97
    s_nop 0
    v_cvt_pk_bf16_f32 v98, v96, v97
    v_lshlrev_b32 v96, 16, v98
    v_and_b32 v97, 0xffff0000, v98
    v_lshlrev_b32 v12, 3, v2
    s_mov_b32 exec_hi, 0xffff
    ds_write_b64 v12, v[96:97] offset:512
    s_mov_b64 exec, -1
    s_waitcnt lgkmcnt(0)
L_waitg:
    s_barrier
    v_and_b32 v14, 15, v2
    v_mul_u32_u24 v12, 24, v14
    ds_read_b64 v[96:97], v12 offset:512
    ds_read_b64 v[98:99], v12 offset:520
    ds_read_b64 v[100:101], v12 offset:528
    s_waitcnt lgkmcnt(0)
    s_mov_b32 s24, 0
    v_lshlrev_b32 v102, 16, v16
    v_and_b32 v103, 0xffff0000, v16
    v_mul_f32 v102, v102, v96
    v_mul_f32 v103, v103, v97
    v_cvt_pk_bf16_f32 v16, v102, v103
    v_lshlrev_b32 v102, 16, v17
    v_and_b32 v103, 0xffff0000, v17
    v_mul_f32 v102, v102, v98
    v_mul_f32 v103, v103, v99
    v_cvt_pk_bf16_f32 v17, v102, v103
    v_lshlrev_b32 v102, 16, v18
    v_and_b32 v103, 0xffff0000, v18
    v_mul_f32 v102, v102, v100
    v_mul_f32 v103, v103, v101
    v_cvt_pk_bf16_f32 v18, v102, v103
    buffer_store_dwordx3 v[16:18], v3, s[20:23], s24 offen
    s_add_u32 s24, s24, 3145728
    v_lshlrev_b32 v102, 16, v20
    v_and_b32 v103, 0xffff0000, v20
    v_mul_f32 v102, v102, v96
    v_mul_f32 v103, v103, v97
    v_cvt_pk_bf16_f32 v20, v102, v103
    v_lshlrev_b32 v102, 16, v21
    v_and_b32 v103, 0xffff0000, v21
    v_mul_f32 v102, v102, v98
    v_mul_f32 v103, v103, v99
    v_cvt_pk_bf16_f32 v21, v102, v103
    v_lshlrev_b32 v102, 16, v22
    v_and_b32 v103, 0xffff0000, v22
    v_mul_f32 v102, v102, v100
    v_mul_f32 v103, v103, v101
    v_cvt_pk_bf16_f32 v22, v102, v103
    buffer_store_dwordx3 v[20:22], v3, s[20:23], s24 offen
    s_add_u32 s24, s24, 3145728
    v_lshlrev_b32 v102, 16, v24
    v_and_b32 v103, 0xffff0000, v24
    v_mul_f32 v102, v102, v96
    v_mul_f32 v103, v103, v97
    v_cvt_pk_bf16_f32 v24, v102, v103
    v_lshlrev_b32 v102, 16, v25
    v_and_b32 v103, 0xffff0000, v25
    v_mul_f32 v102, v102, v98
    v_mul_f32 v103, v103, v99
    v_cvt_pk_bf16_f32 v25, v102, v103
    v_lshlrev_b32 v102, 16, v26
    v_and_b32 v103, 0xffff0000, v26
    v_mul_f32 v102, v102, v100
    v_mul_f32 v103, v103, v101
    v_cvt_pk_bf16_f32 v26, v102, v103
    buffer_store_dwordx3 v[24:26], v3, s[20:23], s24 offen
    s_add_u32 s24, s24, 3145728
    v_lshlrev_b32 v102, 16, v28
    v_and_b32 v103, 0xffff0000, v28
    v_mul_f32 v102, v102, v96
    v_mul_f32 v103, v103, v97
    v_cvt_pk_bf16_f32 v28, v102, v103
    v_lshlrev_b32 v102, 16, v29
    v_and_b32 v103, 0xffff0000, v29
    v_mul_f32 v102, v102, v98
    v_mul_f32 v103, v103, v99
    v_cvt_pk_bf16_f32 v29, v102, v103
    v_lshlrev_b32 v102, 16, v30
    v_and_b32 v103, 0xffff0000, v30
    v_mul_f32 v102, v102, v100
    v_mul_f32 v103, v103, v101
    v_cvt_pk_bf16_f32 v30, v102, v103
    buffer_store_dwordx3 v[28:30], v3, s[20:23], s24 offen
    s_add_u32 s24, s24, 3145728
    v_lshlrev_b32 v102, 16, v32
    v_and_b32 v103, 0xffff0000, v32
    v_mul_f32 v102, v102, v96
    v_mul_f32 v103, v103, v97
    v_cvt_pk_bf16_f32 v32, v102, v103
    v_lshlrev_b32 v102, 16, v33
    v_and_b32 v103, 0xffff0000, v33
    v_mul_f32 v102, v102, v98
    v_mul_f32 v103, v103, v99
    v_cvt_pk_bf16_f32 v33, v102, v103
    v_lshlrev_b32 v102, 16, v34
    v_and_b32 v103, 0xffff0000, v34
    v_mul_f32 v102, v102, v100
    v_mul_f32 v103, v103, v101
    v_cvt_pk_bf16_f32 v34, v102, v103
    buffer_store_dwordx3 v[32:34], v3, s[20:23], s24 offen
    s_add_u32 s24, s24, 3145728
    v_lshlrev_b32 v102, 16, v36
    v_and_b32 v103, 0xffff0000, v36
    v_mul_f32 v102, v102, v96
    v_mul_f32 v103, v103, v97
    v_cvt_pk_bf16_f32 v36, v102, v103
    v_lshlrev_b32 v102, 16, v37
    v_and_b32 v103, 0xffff0000, v37
    v_mul_f32 v102, v102, v98
    v_mul_f32 v103, v103, v99
    v_cvt_pk_bf16_f32 v37, v102, v103
    v_lshlrev_b32 v102, 16, v38
    v_and_b32 v103, 0xffff0000, v38
    v_mul_f32 v102, v102, v100
    v_mul_f32 v103, v103, v101
    v_cvt_pk_bf16_f32 v38, v102, v103
    buffer_store_dwordx3 v[36:38], v3, s[20:23], s24 offen
    s_add_u32 s24, s24, 3145728
    v_lshlrev_b32 v102, 16, v40
    v_and_b32 v103, 0xffff0000, v40
    v_mul_f32 v102, v102, v96
    v_mul_f32 v103, v103, v97
    v_cvt_pk_bf16_f32 v40, v102, v103
    v_lshlrev_b32 v102, 16, v41
    v_and_b32 v103, 0xffff0000, v41
    v_mul_f32 v102, v102, v98
    v_mul_f32 v103, v103, v99
    v_cvt_pk_bf16_f32 v41, v102, v103
    v_lshlrev_b32 v102, 16, v42
    v_and_b32 v103, 0xffff0000, v42
    v_mul_f32 v102, v102, v100
    v_mul_f32 v103, v103, v101
    v_cvt_pk_bf16_f32 v42, v102, v103
    buffer_store_dwordx3 v[40:42], v3, s[20:23], s24 offen
    s_add_u32 s24, s24, 3145728
    v_lshlrev_b32 v102, 16, v44
    v_and_b32 v103, 0xffff0000, v44
    v_mul_f32 v102, v102, v96
    v_mul_f32 v103, v103, v97
    v_cvt_pk_bf16_f32 v44, v102, v103
    v_lshlrev_b32 v102, 16, v45
    v_and_b32 v103, 0xffff0000, v45
    v_mul_f32 v102, v102, v98
    v_mul_f32 v103, v103, v99
    v_cvt_pk_bf16_f32 v45, v102, v103
    v_lshlrev_b32 v102, 16, v46
    v_and_b32 v103, 0xffff0000, v46
    v_mul_f32 v102, v102, v100
    v_mul_f32 v103, v103, v101
    v_cvt_pk_bf16_f32 v46, v102, v103
    buffer_store_dwordx3 v[44:46], v3, s[20:23], s24 offen
    s_add_u32 s24, s24, 3145728
    v_lshlrev_b32 v102, 16, v48
    v_and_b32 v103, 0xffff0000, v48
    v_mul_f32 v102, v102, v96
    v_mul_f32 v103, v103, v97
    v_cvt_pk_bf16_f32 v48, v102, v103
    v_lshlrev_b32 v102, 16, v49
    v_and_b32 v103, 0xffff0000, v49
    v_mul_f32 v102, v102, v98
    v_mul_f32 v103, v103, v99
    v_cvt_pk_bf16_f32 v49, v102, v103
    v_lshlrev_b32 v102, 16, v50
    v_and_b32 v103, 0xffff0000, v50
    v_mul_f32 v102, v102, v100
    v_mul_f32 v103, v103, v101
    v_cvt_pk_bf16_f32 v50, v102, v103
    buffer_store_dwordx3 v[48:50], v3, s[20:23], s24 offen
    s_add_u32 s24, s24, 3145728
    v_lshlrev_b32 v102, 16, v52
    v_and_b32 v103, 0xffff0000, v52
    v_mul_f32 v102, v102, v96
    v_mul_f32 v103, v103, v97
    v_cvt_pk_bf16_f32 v52, v102, v103
    v_lshlrev_b32 v102, 16, v53
    v_and_b32 v103, 0xffff0000, v53
    v_mul_f32 v102, v102, v98
    v_mul_f32 v103, v103, v99
    v_cvt_pk_bf16_f32 v53, v102, v103
    v_lshlrev_b32 v102, 16, v54
    v_and_b32 v103, 0xffff0000, v54
    v_mul_f32 v102, v102, v100
    v_mul_f32 v103, v103, v101
    v_cvt_pk_bf16_f32 v54, v102, v103
    buffer_store_dwordx3 v[52:54], v3, s[20:23], s24 offen
    s_add_u32 s24, s24, 3145728
    v_lshlrev_b32 v102, 16, v56
    v_and_b32 v103, 0xffff0000, v56
    v_mul_f32 v102, v102, v96
    v_mul_f32 v103, v103, v97
    v_cvt_pk_bf16_f32 v56, v102, v103
    v_lshlrev_b32 v102, 16, v57
    v_and_b32 v103, 0xffff0000, v57
    v_mul_f32 v102, v102, v98
    v_mul_f32 v103, v103, v99
    v_cvt_pk_bf16_f32 v57, v102, v103
    v_lshlrev_b32 v102, 16, v58
    v_and_b32 v103, 0xffff0000, v58
    v_mul_f32 v102, v102, v100
    v_mul_f32 v103, v103, v101
    v_cvt_pk_bf16_f32 v58, v102, v103
    buffer_store_dwordx3 v[56:58], v3, s[20:23], s24 offen
    s_add_u32 s24, s24, 3145728
    v_lshlrev_b32 v102, 16, v60
    v_and_b32 v103, 0xffff0000, v60
    v_mul_f32 v102, v102, v96
    v_mul_f32 v103, v103, v97
    v_cvt_pk_bf16_f32 v60, v102, v103
    v_lshlrev_b32 v102, 16, v61
    v_and_b32 v103, 0xffff0000, v61
    v_mul_f32 v102, v102, v98
    v_mul_f32 v103, v103, v99
    v_cvt_pk_bf16_f32 v61, v102, v103
    v_lshlrev_b32 v102, 16, v62
    v_and_b32 v103, 0xffff0000, v62
    v_mul_f32 v102, v102, v100
    v_mul_f32 v103, v103, v101
    v_cvt_pk_bf16_f32 v62, v102, v103
    buffer_store_dwordx3 v[60:62], v3, s[20:23], s24 offen
    s_add_u32 s24, s24, 3145728
    v_lshlrev_b32 v102, 16, v64
    v_and_b32 v103, 0xffff0000, v64
    v_mul_f32 v102, v102, v96
    v_mul_f32 v103, v103, v97
    v_cvt_pk_bf16_f32 v64, v102, v103
    v_lshlrev_b32 v102, 16, v65
    v_and_b32 v103, 0xffff0000, v65
    v_mul_f32 v102, v102, v98
    v_mul_f32 v103, v103, v99
    v_cvt_pk_bf16_f32 v65, v102, v103
    v_lshlrev_b32 v102, 16, v66
    v_and_b32 v103, 0xffff0000, v66
    v_mul_f32 v102, v102, v100
    v_mul_f32 v103, v103, v101
    v_cvt_pk_bf16_f32 v66, v102, v103
    buffer_store_dwordx3 v[64:66], v3, s[20:23], s24 offen
    s_add_u32 s24, s24, 3145728
    v_lshlrev_b32 v102, 16, v68
    v_and_b32 v103, 0xffff0000, v68
    v_mul_f32 v102, v102, v96
    v_mul_f32 v103, v103, v97
    v_cvt_pk_bf16_f32 v68, v102, v103
    v_lshlrev_b32 v102, 16, v69
    v_and_b32 v103, 0xffff0000, v69
    v_mul_f32 v102, v102, v98
    v_mul_f32 v103, v103, v99
    v_cvt_pk_bf16_f32 v69, v102, v103
    v_lshlrev_b32 v102, 16, v70
    v_and_b32 v103, 0xffff0000, v70
    v_mul_f32 v102, v102, v100
    v_mul_f32 v103, v103, v101
    v_cvt_pk_bf16_f32 v70, v102, v103
    buffer_store_dwordx3 v[68:70], v3, s[20:23], s24 offen
    s_add_u32 s24, s24, 3145728
    v_lshlrev_b32 v102, 16, v72
    v_and_b32 v103, 0xffff0000, v72
    v_mul_f32 v102, v102, v96
    v_mul_f32 v103, v103, v97
    v_cvt_pk_bf16_f32 v72, v102, v103
    v_lshlrev_b32 v102, 16, v73
    v_and_b32 v103, 0xffff0000, v73
    v_mul_f32 v102, v102, v98
    v_mul_f32 v103, v103, v99
    v_cvt_pk_bf16_f32 v73, v102, v103
    v_lshlrev_b32 v102, 16, v74
    v_and_b32 v103, 0xffff0000, v74
    v_mul_f32 v102, v102, v100
    v_mul_f32 v103, v103, v101
    v_cvt_pk_bf16_f32 v74, v102, v103
    buffer_store_dwordx3 v[72:74], v3, s[20:23], s24 offen
    s_add_u32 s24, s24, 3145728
    v_lshlrev_b32 v102, 16, v76
    v_and_b32 v103, 0xffff0000, v76
    v_mul_f32 v102, v102, v96
    v_mul_f32 v103, v103, v97
    v_cvt_pk_bf16_f32 v76, v102, v103
    v_lshlrev_b32 v102, 16, v77
    v_and_b32 v103, 0xffff0000, v77
    v_mul_f32 v102, v102, v98
    v_mul_f32 v103, v103, v99
    v_cvt_pk_bf16_f32 v77, v102, v103
    v_lshlrev_b32 v102, 16, v78
    v_and_b32 v103, 0xffff0000, v78
    v_mul_f32 v102, v102, v100
    v_mul_f32 v103, v103, v101
    v_cvt_pk_bf16_f32 v78, v102, v103
    buffer_store_dwordx3 v[76:78], v3, s[20:23], s24 offen
    s_add_u32 s24, s24, 3145728
L_end:
    s_endpgm
.section .rodata,"a"
.p2align 6
.amdhsa_kernel standalone__channel_attn_se__vision_kernel
  .amdhsa_next_free_vgpr 128
  .amdhsa_next_free_sgpr 56
  .amdhsa_accum_offset 128
  .amdhsa_group_segment_fixed_size 0
  .amdhsa_kernarg_size 48
  .amdhsa_user_sgpr_count 2
  .amdhsa_user_sgpr_kernarg_segment_ptr 1
  .amdhsa_system_sgpr_workgroup_id_x 1
.end_amdhsa_kernel
```
